```python
import torch

def _softmax(x, axis=-1):
    return torch.softmax(x, dim=axis)
def _gelu(x):
    return torch.nn.functional.gelu(x, approximate="tanh")
def _silu(x):
    return torch.nn.functional.silu(x)
def _sigmoid(x):
    return torch.sigmoid(x)
def _layernorm(x, axis=-1, eps=1e-5):
    m = x.mean(dim=axis, keepdim=True)
    v = x.var(dim=axis, keepdim=True, unbiased=False)
    return (x - m) / torch.sqrt(v + eps)
def _scatter_add(tgt, idx, src, axis=0):
    return tgt.clone().index_add_(axis, idx, src)
def _segment_sum(src, seg, n):
    out = torch.zeros((n,) + src.shape[1:], dtype=src.dtype)
    return out.index_add_(0, seg, src)
def _pad(x, pw):
    flat = tuple(v for pair in reversed(pw) for v in pair)
    return torch.nn.functional.pad(x, flat)

kernel_name = 'standalone__rmsnorm__sampling'

def setup_inputs():

    _w = (lambda a: (lambda t: t.to(torch.bfloat16) if t.is_floating_point() else t)(torch.as_tensor(a)))
    B, S, D = 1024, 16, 576
    return {
        "x": _w((lambda *s: torch.randn(*s, dtype=torch.bfloat16) * 0.05)(B, S, D)),
        "g": _w((lambda *s: torch.randn(*s, dtype=torch.bfloat16) * 0.05)(D) + 1.0),
    }

def reference(x, g):
    rms = torch.sqrt((x * x).mean(axis=-1, keepdims=True) + 1e-6)
    return x / rms * g
```

```asm
; @launch grid=(512,1,1) block=(256,1,1) lds=4096
.amdgcn_target "amdgcn-amd-amdhsa--gfx950"
.text
.globl standalone__rmsnorm__sampling_kernel
.p2align 8
.type standalone__rmsnorm__sampling_kernel,@function
standalone__rmsnorm__sampling_kernel:
    s_load_dwordx2 s[4:5], s[0:1], 0
    s_load_dwordx2 s[8:9], s[0:1], 8
    s_load_dwordx2 s[12:13], s[0:1], 16
    s_cmp_ge_u32 s2, 512
    s_cbranch_scc1 L_done
    s_mov_b32 s6, 18874368
    s_mov_b32 s7, 0x00020000
    s_mov_b32 s10, 1152
    s_mov_b32 s11, 0x00020000
    s_mov_b32 s14, 18874368
    s_mov_b32 s15, 0x00020000
    v_and_b32 v2, 7, v0
    s_mul_i32 s3, s2, 36864
    v_lshrrev_b32 v1, 3, v0
    v_mul_u32_u24 v1, 1152, v1
    v_lshl_add_u32 v1, v2, 4, v1
    v_lshlrev_b32 v2, 5, v2
    v_lshlrev_b32 v3, 3, v0
    v_lshlrev_b32 v6, 4, v0
    s_mov_b32 s16, 0xffff0000
    s_mov_b32 s17, 0x0000ffff
    v_mov_b32 v4, 0
    v_mov_b32 v5, 0
    s_waitcnt lgkmcnt(0)
    buffer_load_dwordx2 v[8:9], v3, s[8:11], 0 offen
    buffer_load_dwordx4 v[12:15], v1, s[4:7], s3 offen offset:0 nt
    buffer_load_dwordx4 v[16:19], v1, s[4:7], s3 offen offset:128 nt
    buffer_load_dwordx4 v[20:23], v1, s[4:7], s3 offen offset:256 nt
    buffer_load_dwordx4 v[24:27], v1, s[4:7], s3 offen offset:384 nt
    buffer_load_dwordx4 v[28:31], v1, s[4:7], s3 offen offset:512 nt
    buffer_load_dwordx4 v[32:35], v1, s[4:7], s3 offen offset:640 nt
    buffer_load_dwordx4 v[36:39], v1, s[4:7], s3 offen offset:768 nt
    buffer_load_dwordx4 v[40:43], v1, s[4:7], s3 offen offset:896 nt
    buffer_load_dwordx4 v[44:47], v1, s[4:7], s3 offen offset:1024 nt
    s_waitcnt vmcnt(9)
    v_and_b32 v120, s17, v8
    v_and_b32 v121, s16, v8
    v_and_b32 v122, s17, v9
    v_and_b32 v123, s16, v9
    ds_write_b128 v6, v[120:123]
    s_waitcnt lgkmcnt(0)
    s_barrier
    ds_read_b128 v[48:51], v2 offset:0
    ds_read_b128 v[52:55], v2 offset:16
    ds_read_b128 v[56:59], v2 offset:256
    ds_read_b128 v[60:63], v2 offset:272
    ds_read_b128 v[64:67], v2 offset:512
    ds_read_b128 v[68:71], v2 offset:528
    ds_read_b128 v[72:75], v2 offset:768
    ds_read_b128 v[76:79], v2 offset:784
    ds_read_b128 v[80:83], v2 offset:1024
    ds_read_b128 v[84:87], v2 offset:1040
    ds_read_b128 v[88:91], v2 offset:1280
    ds_read_b128 v[92:95], v2 offset:1296
    ds_read_b128 v[96:99], v2 offset:1536
    ds_read_b128 v[100:103], v2 offset:1552
    ds_read_b128 v[104:107], v2 offset:1792
    ds_read_b128 v[108:111], v2 offset:1808
    ds_read_b128 v[112:115], v2 offset:2048
    ds_read_b128 v[116:119], v2 offset:2064
    s_waitcnt vmcnt(8)
    v_dot2c_f32_bf16 v4, v12, v12
    v_dot2c_f32_bf16 v5, v13, v13
    v_dot2c_f32_bf16 v4, v14, v14
    v_dot2c_f32_bf16 v5, v15, v15
    s_waitcnt lgkmcnt(0)
    v_dot2_f32_bf16 v48, v12, v48, 0
    v_dot2_f32_bf16 v49, v12, v49, 0
    v_dot2_f32_bf16 v50, v13, v50, 0
    v_dot2_f32_bf16 v51, v13, v51, 0
    v_dot2_f32_bf16 v52, v14, v52, 0
    v_dot2_f32_bf16 v53, v14, v53, 0
    v_dot2_f32_bf16 v54, v15, v54, 0
    v_dot2_f32_bf16 v55, v15, v55, 0
    s_waitcnt vmcnt(7)
    v_dot2c_f32_bf16 v4, v16, v16
    v_dot2c_f32_bf16 v5, v17, v17
    v_dot2c_f32_bf16 v4, v18, v18
    v_dot2c_f32_bf16 v5, v19, v19
    v_dot2_f32_bf16 v56, v16, v56, 0
    v_dot2_f32_bf16 v57, v16, v57, 0
    v_dot2_f32_bf16 v58, v17, v58, 0
    v_dot2_f32_bf16 v59, v17, v59, 0
    v_dot2_f32_bf16 v60, v18, v60, 0
    v_dot2_f32_bf16 v61, v18, v61, 0
    v_dot2_f32_bf16 v62, v19, v62, 0
    v_dot2_f32_bf16 v63, v19, v63, 0
    s_waitcnt vmcnt(6)
    v_dot2c_f32_bf16 v4, v20, v20
    v_dot2c_f32_bf16 v5, v21, v21
    v_dot2c_f32_bf16 v4, v22, v22
    v_dot2c_f32_bf16 v5, v23, v23
    v_dot2_f32_bf16 v64, v20, v64, 0
    v_dot2_f32_bf16 v65, v20, v65, 0
    v_dot2_f32_bf16 v66, v21, v66, 0
    v_dot2_f32_bf16 v67, v21, v67, 0
    v_dot2_f32_bf16 v68, v22, v68, 0
    v_dot2_f32_bf16 v69, v22, v69, 0
    v_dot2_f32_bf16 v70, v23, v70, 0
    v_dot2_f32_bf16 v71, v23, v71, 0
    s_waitcnt vmcnt(5)
    v_dot2c_f32_bf16 v4, v24, v24
    v_dot2c_f32_bf16 v5, v25, v25
    v_dot2c_f32_bf16 v4, v26, v26
    v_dot2c_f32_bf16 v5, v27, v27
    v_dot2_f32_bf16 v72, v24, v72, 0
    v_dot2_f32_bf16 v73, v24, v73, 0
    v_dot2_f32_bf16 v74, v25, v74, 0
    v_dot2_f32_bf16 v75, v25, v75, 0
    v_dot2_f32_bf16 v76, v26, v76, 0
    v_dot2_f32_bf16 v77, v26, v77, 0
    v_dot2_f32_bf16 v78, v27, v78, 0
    v_dot2_f32_bf16 v79, v27, v79, 0
    s_waitcnt vmcnt(4)
    v_dot2c_f32_bf16 v4, v28, v28
    v_dot2c_f32_bf16 v5, v29, v29
    v_dot2c_f32_bf16 v4, v30, v30
    v_dot2c_f32_bf16 v5, v31, v31
    v_dot2_f32_bf16 v80, v28, v80, 0
    v_dot2_f32_bf16 v81, v28, v81, 0
    v_dot2_f32_bf16 v82, v29, v82, 0
    v_dot2_f32_bf16 v83, v29, v83, 0
    v_dot2_f32_bf16 v84, v30, v84, 0
    v_dot2_f32_bf16 v85, v30, v85, 0
    v_dot2_f32_bf16 v86, v31, v86, 0
    v_dot2_f32_bf16 v87, v31, v87, 0
    s_waitcnt vmcnt(3)
    v_dot2c_f32_bf16 v4, v32, v32
    v_dot2c_f32_bf16 v5, v33, v33
    v_dot2c_f32_bf16 v4, v34, v34
    v_dot2c_f32_bf16 v5, v35, v35
    v_dot2_f32_bf16 v88, v32, v88, 0
    v_dot2_f32_bf16 v89, v32, v89, 0
    v_dot2_f32_bf16 v90, v33, v90, 0
    v_dot2_f32_bf16 v91, v33, v91, 0
    v_dot2_f32_bf16 v92, v34, v92, 0
    v_dot2_f32_bf16 v93, v34, v93, 0
    v_dot2_f32_bf16 v94, v35, v94, 0
    v_dot2_f32_bf16 v95, v35, v95, 0
    s_waitcnt vmcnt(2)
    v_dot2c_f32_bf16 v4, v36, v36
    v_dot2c_f32_bf16 v5, v37, v37
    v_dot2c_f32_bf16 v4, v38, v38
    v_dot2c_f32_bf16 v5, v39, v39
    v_dot2_f32_bf16 v96, v36, v96, 0
    v_dot2_f32_bf16 v97, v36, v97, 0
    v_dot2_f32_bf16 v98, v37, v98, 0
    v_dot2_f32_bf16 v99, v37, v99, 0
    v_dot2_f32_bf16 v100, v38, v100, 0
    v_dot2_f32_bf16 v101, v38, v101, 0
    v_dot2_f32_bf16 v102, v39, v102, 0
    v_dot2_f32_bf16 v103, v39, v103, 0
    s_waitcnt vmcnt(1)
    v_dot2c_f32_bf16 v4, v40, v40
    v_dot2c_f32_bf16 v5, v41, v41
    v_dot2c_f32_bf16 v4, v42, v42
    v_dot2c_f32_bf16 v5, v43, v43
    v_dot2_f32_bf16 v104, v40, v104, 0
    v_dot2_f32_bf16 v105, v40, v105, 0
    v_dot2_f32_bf16 v106, v41, v106, 0
    v_dot2_f32_bf16 v107, v41, v107, 0
    v_dot2_f32_bf16 v108, v42, v108, 0
    v_dot2_f32_bf16 v109, v42, v109, 0
    v_dot2_f32_bf16 v110, v43, v110, 0
    v_dot2_f32_bf16 v111, v43, v111, 0
    s_waitcnt vmcnt(0)
    v_dot2c_f32_bf16 v4, v44, v44
    v_dot2c_f32_bf16 v5, v45, v45
    v_dot2c_f32_bf16 v4, v46, v46
    v_dot2c_f32_bf16 v5, v47, v47
    v_dot2_f32_bf16 v112, v44, v112, 0
    v_dot2_f32_bf16 v113, v44, v113, 0
    v_dot2_f32_bf16 v114, v45, v114, 0
    v_add_f32 v4, v4, v5
    v_dot2_f32_bf16 v115, v45, v115, 0
    v_dot2_f32_bf16 v116, v46, v116, 0
    v_add_f32_dpp v4, v4, v4 quad_perm:[1,0,3,2] row_mask:0xf bank_mask:0xf
    v_dot2_f32_bf16 v117, v46, v117, 0
    v_dot2_f32_bf16 v118, v47, v118, 0
    v_add_f32_dpp v4, v4, v4 quad_perm:[2,3,0,1] row_mask:0xf bank_mask:0xf
    v_mov_b32 v5, 0x358637bd
    v_dot2_f32_bf16 v119, v47, v119, 0
    v_add_f32_dpp v4, v4, v4 row_half_mirror row_mask:0xf bank_mask:0xf
    v_fmac_f32 v5, 0x3ae38e39, v4
    v_rsq_f32 v4, v5
    s_nop 2
    v_pk_mul_f32 v[48:49], v[48:49], v[4:5] op_sel_hi:[1,0]
    v_pk_mul_f32 v[50:51], v[50:51], v[4:5] op_sel_hi:[1,0]
    v_pk_mul_f32 v[52:53], v[52:53], v[4:5] op_sel_hi:[1,0]
    v_pk_mul_f32 v[54:55], v[54:55], v[4:5] op_sel_hi:[1,0]
    v_cvt_pk_bf16_f32 v12, v48, v49
    v_cvt_pk_bf16_f32 v13, v50, v51
    v_cvt_pk_bf16_f32 v14, v52, v53
    v_cvt_pk_bf16_f32 v15, v54, v55
    buffer_store_dwordx4 v[12:15], v1, s[12:15], s3 offen offset:0 nt
    v_pk_mul_f32 v[56:57], v[56:57], v[4:5] op_sel_hi:[1,0]
    v_pk_mul_f32 v[58:59], v[58:59], v[4:5] op_sel_hi:[1,0]
    v_pk_mul_f32 v[60:61], v[60:61], v[4:5] op_sel_hi:[1,0]
    v_pk_mul_f32 v[62:63], v[62:63], v[4:5] op_sel_hi:[1,0]
    v_cvt_pk_bf16_f32 v16, v56, v57
    v_cvt_pk_bf16_f32 v17, v58, v59
    v_cvt_pk_bf16_f32 v18, v60, v61
    v_cvt_pk_bf16_f32 v19, v62, v63
    buffer_store_dwordx4 v[16:19], v1, s[12:15], s3 offen offset:128 nt
    v_pk_mul_f32 v[64:65], v[64:65], v[4:5] op_sel_hi:[1,0]
    v_pk_mul_f32 v[66:67], v[66:67], v[4:5] op_sel_hi:[1,0]
    v_pk_mul_f32 v[68:69], v[68:69], v[4:5] op_sel_hi:[1,0]
    v_pk_mul_f32 v[70:71], v[70:71], v[4:5] op_sel_hi:[1,0]
    v_cvt_pk_bf16_f32 v20, v64, v65
    v_cvt_pk_bf16_f32 v21, v66, v67
    v_cvt_pk_bf16_f32 v22, v68, v69
    v_cvt_pk_bf16_f32 v23, v70, v71
    buffer_store_dwordx4 v[20:23], v1, s[12:15], s3 offen offset:256 nt
    v_pk_mul_f32 v[72:73], v[72:73], v[4:5] op_sel_hi:[1,0]
    v_pk_mul_f32 v[74:75], v[74:75], v[4:5] op_sel_hi:[1,0]
    v_pk_mul_f32 v[76:77], v[76:77], v[4:5] op_sel_hi:[1,0]
    v_pk_mul_f32 v[78:79], v[78:79], v[4:5] op_sel_hi:[1,0]
    v_cvt_pk_bf16_f32 v24, v72, v73
    v_cvt_pk_bf16_f32 v25, v74, v75
    v_cvt_pk_bf16_f32 v26, v76, v77
    v_cvt_pk_bf16_f32 v27, v78, v79
    buffer_store_dwordx4 v[24:27], v1, s[12:15], s3 offen offset:384 nt
    v_pk_mul_f32 v[80:81], v[80:81], v[4:5] op_sel_hi:[1,0]
    v_pk_mul_f32 v[82:83], v[82:83], v[4:5] op_sel_hi:[1,0]
    v_pk_mul_f32 v[84:85], v[84:85], v[4:5] op_sel_hi:[1,0]
    v_pk_mul_f32 v[86:87], v[86:87], v[4:5] op_sel_hi:[1,0]
    v_cvt_pk_bf16_f32 v28, v80, v81
    v_cvt_pk_bf16_f32 v29, v82, v83
    v_cvt_pk_bf16_f32 v30, v84, v85
    v_cvt_pk_bf16_f32 v31, v86, v87
    buffer_store_dwordx4 v[28:31], v1, s[12:15], s3 offen offset:512 nt
    v_pk_mul_f32 v[88:89], v[88:89], v[4:5] op_sel_hi:[1,0]
    v_pk_mul_f32 v[90:91], v[90:91], v[4:5] op_sel_hi:[1,0]
    v_pk_mul_f32 v[92:93], v[92:93], v[4:5] op_sel_hi:[1,0]
    v_pk_mul_f32 v[94:95], v[94:95], v[4:5] op_sel_hi:[1,0]
    v_cvt_pk_bf16_f32 v32, v88, v89
    v_cvt_pk_bf16_f32 v33, v90, v91
    v_cvt_pk_bf16_f32 v34, v92, v93
    v_cvt_pk_bf16_f32 v35, v94, v95
    buffer_store_dwordx4 v[32:35], v1, s[12:15], s3 offen offset:640 nt
    v_pk_mul_f32 v[96:97], v[96:97], v[4:5] op_sel_hi:[1,0]
    v_pk_mul_f32 v[98:99], v[98:99], v[4:5] op_sel_hi:[1,0]
    v_pk_mul_f32 v[100:101], v[100:101], v[4:5] op_sel_hi:[1,0]
    v_pk_mul_f32 v[102:103], v[102:103], v[4:5] op_sel_hi:[1,0]
    v_cvt_pk_bf16_f32 v36, v96, v97
    v_cvt_pk_bf16_f32 v37, v98, v99
    v_cvt_pk_bf16_f32 v38, v100, v101
    v_cvt_pk_bf16_f32 v39, v102, v103
    buffer_store_dwordx4 v[36:39], v1, s[12:15], s3 offen offset:768 nt
    v_pk_mul_f32 v[104:105], v[104:105], v[4:5] op_sel_hi:[1,0]
    v_pk_mul_f32 v[106:107], v[106:107], v[4:5] op_sel_hi:[1,0]
    v_pk_mul_f32 v[108:109], v[108:109], v[4:5] op_sel_hi:[1,0]
    v_pk_mul_f32 v[110:111], v[110:111], v[4:5] op_sel_hi:[1,0]
    v_cvt_pk_bf16_f32 v40, v104, v105
    v_cvt_pk_bf16_f32 v41, v106, v107
    v_cvt_pk_bf16_f32 v42, v108, v109
    v_cvt_pk_bf16_f32 v43, v110, v111
    buffer_store_dwordx4 v[40:43], v1, s[12:15], s3 offen offset:896 nt
    v_pk_mul_f32 v[112:113], v[112:113], v[4:5] op_sel_hi:[1,0]
    v_pk_mul_f32 v[114:115], v[114:115], v[4:5] op_sel_hi:[1,0]
    v_pk_mul_f32 v[116:117], v[116:117], v[4:5] op_sel_hi:[1,0]
    v_pk_mul_f32 v[118:119], v[118:119], v[4:5] op_sel_hi:[1,0]
    v_cvt_pk_bf16_f32 v44, v112, v113
    v_cvt_pk_bf16_f32 v45, v114, v115
    v_cvt_pk_bf16_f32 v46, v116, v117
    v_cvt_pk_bf16_f32 v47, v118, v119
    buffer_store_dwordx4 v[44:47], v1, s[12:15], s3 offen offset:1024 nt
L_done:
    s_endpgm
.section .rodata,"a"
.p2align 6
.amdhsa_kernel standalone__rmsnorm__sampling_kernel
  .amdhsa_next_free_vgpr 128
  .amdhsa_next_free_sgpr 40
  .amdhsa_accum_offset 128
  .amdhsa_group_segment_fixed_size 0
  .amdhsa_kernarg_size 40
  .amdhsa_user_sgpr_count 2
  .amdhsa_user_sgpr_kernarg_segment_ptr 1
  .amdhsa_system_sgpr_workgroup_id_x 1
  .amdhsa_float_denorm_mode_32 3
.end_amdhsa_kernel
```
